```python
import torch

def _softmax(x, axis=-1):
    return torch.softmax(x, dim=axis)
def _gelu(x):
    return torch.nn.functional.gelu(x, approximate="tanh")
def _silu(x):
    return torch.nn.functional.silu(x)
def _sigmoid(x):
    return torch.sigmoid(x)
def _layernorm(x, axis=-1, eps=1e-5):
    m = x.mean(dim=axis, keepdim=True)
    v = x.var(dim=axis, keepdim=True, unbiased=False)
    return (x - m) / torch.sqrt(v + eps)
def _scatter_add(tgt, idx, src, axis=0):
    return tgt.clone().index_add_(axis, idx, src)
def _segment_sum(src, seg, n):
    out = torch.zeros((n,) + src.shape[1:], dtype=src.dtype)
    return out.index_add_(0, seg, src)
def _pad(x, pw):
    flat = tuple(v for pair in reversed(pw) for v in pair)
    return torch.nn.functional.pad(x, flat)

kernel_name = 'standalone__geglu_ffn__decode'

def setup_inputs():

    _w = (lambda a: (lambda t: t.to(torch.bfloat16) if t.is_floating_point() else t)(torch.as_tensor(a)))
    B, S, D, F = 4, 1, 1024, 3584
    return {
        "x": _w((lambda *s: torch.randn(*s, dtype=torch.bfloat16) * 0.05)(B, S, D)),
        "w_gate": _w((lambda *s: torch.randn(*s, dtype=torch.bfloat16) * 0.05)(D, F)),
        "w_up": _w((lambda *s: torch.randn(*s, dtype=torch.bfloat16) * 0.05)(D, F)),
        "w_down": _w((lambda *s: torch.randn(*s, dtype=torch.bfloat16) * 0.05)(F, D)),
    }

def reference(x, w_gate, w_up, w_down):
    return (_gelu(x @ w_gate) * (x @ w_up)) @ w_down
```

```asm
; @launch grid=(256,1,1) block=(256,1,1) lds=12352
.amdgcn_target "amdgcn-amd-amdhsa--gfx950"
.text
.globl standalone__geglu_ffn__decode_kernel
.p2align 8
.type standalone__geglu_ffn__decode_kernel,@function
standalone__geglu_ffn__decode_kernel:
  s_cmp_ge_u32 s2, 256
  s_cbranch_scc1 L_end
  s_load_dwordx8 s[4:11], s[0:1], 0
  s_load_dwordx2 s[16:17], s[0:1], 48
  s_load_dwordx2 s[12:13], s[0:1], 32
  v_lshrrev_b32 v1, 6, v0
  v_and_b32 v0, 63, v0
  s_and_b32 s40, s2, 7
  v_readfirstlane_b32 s3, v1
  s_lshr_b32 s41, s2, 3
  s_lshl_b32 s14, s40, 2
  s_lshr_b32 s14, 0x76435120, s14
  s_and_b32 s14, s14, 7
  v_lshrrev_b32 v2, 4, v0
  v_and_b32 v3, 15, v0
  s_mov_b32 s22, 7340032
  s_mov_b32 s23, 0x20000
  s_mov_b32 s30, 8192
  s_mov_b32 s31, 0x20000
  s_mov_b32 s48, 7168
  s_mov_b32 s49, 14336
  s_mov_b32 s50, 21504
  s_mov_b32 s51, 28672
  s_mov_b32 s52, 35840
  s_mov_b32 s53, 43008
  s_mov_b32 s54, 50176
  v_mul_u32_u24 v4, 57344, v2
  v_and_b32 v5, 7, v3
  v_lshl_add_u32 v4, v5, 4, v4
  v_lshrrev_b32 v5, 3, v3
  v_mul_u32_u24 v5, 229376, v5
  v_lshrrev_b32 v6, 2, v3
  v_lshlrev_b32 v6, 11, v6
  v_lshl_add_u32 v6, v2, 4, v6
  v_and_b32 v7, 1, v3
  v_lshl_add_u32 v6, v7, 6, v6
  s_lshl_b32 s72, s40, 3
  s_mov_b32 s42, 0x6060618
  s_mov_b32 s43, 0x5050606
  s_lshr_b64 s[42:43], s[42:43], s72
  s_and_b32 s42, s42, 0xff
  s_mov_b32 s44, 0x241e1800
  s_mov_b32 s45, 0x3b36302a
  s_lshr_b64 s[44:45], s[44:45], s72
  s_and_b32 s44, s44, 0xff
  s_mov_b32 s46, 0x3c220800
  s_mov_b32 s47, 0xa58a7056
  s_lshr_b64 s[46:47], s[46:47], s72
  s_and_b32 s46, s46, 0xff
  s_add_u32 s19, s44, s41
  s_add_u32 s18, s46, s41
  s_sub_u32 s18, s18, s42
  s_cmp_lt_u32 s41, s42
  s_cbranch_scc1 L_odd
L_fast:
  s_and_b32 s47, s18, 3
  s_lshr_b32 s18, s18, 2
  s_add_u32 s45, s18, 4
  s_mul_i32 s45, s45, 37
  s_lshr_b32 s45, s45, 8
  s_add_u32 s18, s18, s45
  s_lshr_b32 s43, s47, 1
  s_lshl_b32 s43, s43, 2
  s_add_u32 s43, s43, s3
  s_lshl_b32 s43, s43, 1
  s_mul_i32 s44, s43, 458752
  s_lshl_b32 s45, s18, 7
  s_add_u32 s44, s44, s45
  v_add3_u32 v4, v4, v5, s44
  s_lshl_b32 s45, s43, 7
  v_add_u32 v6, s45, v6
  v_add_u32 v10, 458752, v4
  s_and_b32 s46, s47, 1
  s_waitcnt lgkmcnt(0)
  s_load_dword s66, s[16:17], 0
  s_cselect_b32 s20, s8, s6
  s_cselect_b32 s21, s9, s7
  s_mov_b32 s28, s4
  s_mov_b32 s29, s5
  buffer_load_dwordx4 v[24:27], v4, s[20:23], 0 offen nt
  buffer_load_dwordx4 v[28:31], v4, s[20:23], s48 offen nt
  buffer_load_dwordx4 v[32:35], v4, s[20:23], s49 offen nt
  buffer_load_dwordx4 v[36:39], v4, s[20:23], s50 offen nt
  buffer_load_dwordx4 v[40:43], v4, s[20:23], s51 offen nt
  buffer_load_dwordx4 v[44:47], v4, s[20:23], s52 offen nt
  buffer_load_dwordx4 v[48:51], v4, s[20:23], s53 offen nt
  buffer_load_dwordx4 v[16:19], v6, s[28:31], 0 offen offset:0
  buffer_load_dwordx4 v[20:23], v6, s[28:31], 0 offen offset:128
  buffer_load_dwordx4 v[52:55], v4, s[20:23], s54 offen nt
  buffer_load_dwordx4 v[56:59], v10, s[20:23], 0 offen nt
  buffer_load_dwordx4 v[60:63], v10, s[20:23], s48 offen nt
  buffer_load_dwordx4 v[64:67], v10, s[20:23], s49 offen nt
  buffer_load_dwordx4 v[68:71], v10, s[20:23], s50 offen nt
  buffer_load_dwordx4 v[72:75], v10, s[20:23], s51 offen nt
  buffer_load_dwordx4 v[76:79], v10, s[20:23], s52 offen nt
  buffer_load_dwordx4 v[80:83], v10, s[20:23], s53 offen nt
  buffer_load_dwordx4 v[84:87], v10, s[20:23], s54 offen nt
  s_mov_b32 s34, 0x400000
  s_mov_b32 s35, 0x20000
  s_mov_b32 s32, s16
  s_mov_b32 s33, s17
  s_lshr_b32 s72, s41, 2
  s_lshl_b32 s72, s72, 9
  s_and_b32 s73, s41, 3
  s_lshl_b32 s73, s73, 6
  s_add_u32 s72, s72, s73
  s_lshl_b32 s73, s40, 17
  s_add_u32 s73, s73, 1048576
  s_add_u32 s72, s72, s73
  s_cmp_eq_u32 s3, 2
  s_cselect_b32 s72, s72, 0x80000000
  v_lshrrev_b32 v8, 2, v0
  v_lshlrev_b32 v8, 12, v8
  v_and_b32 v9, 3, v0
  v_lshlrev_b32 v9, 4, v9
  v_add3_u32 v252, v8, v9, s72
  v_add_u32 v253, 0x10000, v252
  s_lshl_b32 s45, s41, 2
  s_add_u32 s45, s45, s3
  s_mul_i32 s46, s45, 57344
  s_lshl_b32 s44, s14, 8
  s_add_u32 s46, s46, s44
  v_and_b32 v7, 1, v2
  v_lshlrev_b32 v1, 31, v7
  v_lshlrev_b32 v7, 15, v7
  v_lshrrev_b32 v8, 1, v2
  v_lshlrev_b32 v8, 12, v8
  v_lshl_add_u32 v8, v3, 4, v8
  v_add3_u32 v7, v7, v8, s46
  v_or_b32 v1, v1, v7
  s_mov_b32 s63, 8192
  s_mov_b32 s64, 16384
  s_mov_b32 s65, 24576
  s_mov_b32 s26, 7340032
  s_mov_b32 s27, 0x20000
  s_mov_b32 s24, s10
  s_mov_b32 s25, s11
  v_lshlrev_b32 v8, 31, v0
  v_or_b32 v8, v8, v7
  buffer_load_dword v220, v8, s[24:27], 0 offen nt
  s_mov_b32 s38, 8192
  s_mov_b32 s39, 0x20000
  s_mov_b32 s36, s12
  s_mov_b32 s37, s13
  s_mov_b32 s67, 0x05040100
  s_mov_b32 s68, 0x07060302
  s_mov_b32 s69, 0xfffff000
  s_mov_b32 s55, 229376
  s_mov_b32 s56, 458752
  s_mov_b32 s57, 688128
  s_getreg_b32 s79, hwreg(HW_REG_XCC_ID, 0, 3)
  s_mul_i32 s71, s47, 114688
  s_lshl_b32 s72, s18, 9
  s_add_u32 s71, s71, s72
  s_add_u32 s71, s71, 4096
  v_mul_u32_u24 v8, 28672, v2
  v_lshl_add_u32 v8, v3, 4, v8
  v_add_u32 v8, s71, v8
  s_cmp_eq_u32 s3, 0
  s_cselect_b32 s72, 0, 0x80000000
  v_add_u32 v10, s72, v8
  buffer_load_dwordx4 v[216:219], v10, s[32:35], 0 offen
  s_lshl_b32 s72, s3, 10
  v_lshl_add_u32 v15, v0, 4, s72
  v_and_b32 v13, 1, v0
  v_lshlrev_b32 v13, 7, v13
  v_lshl_add_u32 v13, v2, 8, v13
  v_and_b32 v10, 14, v0
  v_lshl_add_u32 v13, v10, 3, v13
  s_mul_i32 s72, s45, 7
  v_and_b32 v10, 3, v0
  v_bfe_u32 v9, v0, 4, 1
  v_lshl_add_u32 v10, v9, 2, v10
  v_add_u32 v10, s72, v10
  v_and_b32 v9, 15, v10
  v_lshrrev_b32 v10, 4, v10
  v_and_b32 v11, 7, v10
  v_cmp_eq_u32 s[60:61], 3, v11
  v_cmp_eq_u32 s[42:43], 55, v10
  v_lshlrev_b32 v10, 9, v10
  v_lshl_add_u32 v10, v9, 4, v10
  v_lshrrev_b32 v9, 5, v0
  v_mul_u32_u24 v9, 114688, v9
  v_add_u32 v9, v9, v10
  v_and_b32 v10, 12, v0
  v_mul_u32_u24 v10, 7168, v10
  s_mov_b32 s72, 4096
  v_add3_u32 v9, v9, v10, s72
  v_and_b32 v10, 19, v0
  v_cmp_eq_u32 s[58:59], 19, v10
  v_mov_b32 v10, 0x80000000
  s_lshl_b32 s72, s41, 12
  s_add_u32 s72, s72, s73
  s_or_b64 s[60:61], s[60:61], s[42:43]
  s_andn2_b64 s[60:61], s[60:61], s[58:59]
  v_cndmask_b32 v9, v9, v10, s[58:59]
  s_lshl_b32 s74, s3, 11
  s_add_u32 s72, s72, s74
  v_cndmask_b32 v251, v10, v9, s[60:61]
  v_lshlrev_b32 v10, 9, v2
  v_lshl_add_u32 v10, v3, 4, v10
  v_add_u32 v11, s72, v10
  v_lshlrev_b32 v12, 2, v0
  s_lshl_b32 s72, s3, 10
  v_add_u32 v248, s72, v12
  v_add_u32 v12, s74, v12
  v_mov_b32 v10, 0
  ds_write_b32 v10, v10 offset:12288
  s_bfe_u32 s72, s41, 0x20002
  s_lshl_b32 s72, s72, 11
  s_add_u32 s72, s72, s44
  s_and_b32 s74, s41, 3
  s_lshl_b32 s74, s74, 6
  s_add_u32 s72, s72, s74
  s_lshr_b32 s74, s41, 4
  s_lshl_b32 s74, s74, 3
  s_add_u32 s72, s72, s74
  v_and_b32 v254, 1, v2
  v_lshrrev_b32 v10, 1, v2
  v_lshl_add_u32 v254, v254, 1, v10
  v_lshlrev_b32 v254, 1, v254
  v_lshl_add_u32 v254, v3, 4, v254
  v_add_u32 v254, s72, v254
  v_cmp_gt_u32 vcc, 4, v3
  v_mov_b32 v10, 0x80000000
  s_nop 0
  v_cndmask_b32 v254, v10, v254, vcc
  s_waitcnt vmcnt(18)
  v_perm_b32 v120, v28, v24, s67
  v_perm_b32 v124, v28, v24, s68
  v_perm_b32 v128, v29, v25, s67
  v_perm_b32 v132, v29, v25, s68
  v_perm_b32 v136, v30, v26, s67
  v_perm_b32 v140, v30, v26, s68
  v_perm_b32 v144, v31, v27, s67
  v_perm_b32 v148, v31, v27, s68
  s_waitcnt lgkmcnt(0)
  s_add_u32 s76, s66, 2
  s_or_b32 s76, s76, 1
  s_and_b32 s76, s76, 0xfff
  v_mov_b32 v14, s76
  s_and_b32 s74, s76, 0xff8
  s_or_b32 s79, s79, s74
  v_cndmask_b32 v249, v14, 0, s[58:59]
  v_cndmask_b32 v250, 0, v14, s[60:61]
  v_mov_b32 v224, 0
  v_mov_b32 v225, 0
  v_mov_b32 v226, 0
  v_mov_b32 v227, 0
  v_mov_b32 v228, 0
  v_mov_b32 v229, 0
  v_mov_b32 v230, 0
  v_mov_b32 v231, 0
  s_waitcnt vmcnt(16)
  s_barrier
  buffer_load_dwordx4 v[112:115], v1, s[24:27], s65 offen offset:0 nt
  buffer_load_dwordx4 v[116:119], v1, s[24:27], s65 offen offset:2048 nt
  buffer_load_dwordx4 v[88:91], v7, s[24:27], 0 offen offset:0 nt
  buffer_load_dwordx4 v[92:95], v7, s[24:27], 0 offen offset:2048 nt
  buffer_load_dwordx4 v[96:99], v7, s[24:27], s63 offen offset:0 nt
  v_perm_b32 v121, v36, v32, s67
  v_perm_b32 v125, v36, v32, s68
  v_perm_b32 v129, v37, v33, s67
  v_perm_b32 v133, v37, v33, s68
  v_perm_b32 v137, v38, v34, s67
  v_perm_b32 v141, v38, v34, s68
  v_perm_b32 v145, v39, v35, s67
  v_perm_b32 v149, v39, v35, s68
  s_waitcnt vmcnt(19)
  v_perm_b32 v122, v44, v40, s67
  v_perm_b32 v126, v44, v40, s68
  v_perm_b32 v130, v45, v41, s67
  v_perm_b32 v134, v45, v41, s68
  v_perm_b32 v138, v46, v42, s67
  v_perm_b32 v142, v46, v42, s68
  v_perm_b32 v146, v47, v43, s67
  v_perm_b32 v150, v47, v43, s68
  s_waitcnt vmcnt(15)
  v_perm_b32 v123, v52, v48, s67
  v_perm_b32 v127, v52, v48, s68
  v_perm_b32 v131, v53, v49, s67
  v_perm_b32 v135, v53, v49, s68
  v_perm_b32 v139, v54, v50, s67
  v_perm_b32 v143, v54, v50, s68
  v_perm_b32 v147, v55, v51, s67
  v_perm_b32 v151, v55, v51, s68
  v_mfma_f32_16x16x32_bf16 v[184:187], v[16:19], v[120:123], 0
  v_mfma_f32_16x16x32_bf16 v[188:191], v[16:19], v[124:127], 0
  v_mfma_f32_16x16x32_bf16 v[192:195], v[16:19], v[128:131], 0
  v_mfma_f32_16x16x32_bf16 v[196:199], v[16:19], v[132:135], 0
  v_mfma_f32_16x16x32_bf16 v[200:203], v[16:19], v[136:139], 0
  v_mfma_f32_16x16x32_bf16 v[204:207], v[16:19], v[140:143], 0
  v_mfma_f32_16x16x32_bf16 v[208:211], v[16:19], v[144:147], 0
  v_mfma_f32_16x16x32_bf16 v[212:215], v[16:19], v[148:151], 0
  s_waitcnt vmcnt(13)
  v_perm_b32 v152, v60, v56, s67
  v_perm_b32 v156, v60, v56, s68
  v_perm_b32 v160, v61, v57, s67
  v_perm_b32 v164, v61, v57, s68
  v_perm_b32 v168, v62, v58, s67
  v_perm_b32 v172, v62, v58, s68
  v_perm_b32 v176, v63, v59, s67
  v_perm_b32 v180, v63, v59, s68
  s_waitcnt vmcnt(11)
  v_perm_b32 v153, v68, v64, s67
  v_perm_b32 v157, v68, v64, s68
  v_perm_b32 v161, v69, v65, s67
  v_perm_b32 v165, v69, v65, s68
  v_perm_b32 v169, v70, v66, s67
  v_perm_b32 v173, v70, v66, s68
  v_perm_b32 v177, v71, v67, s67
  v_perm_b32 v181, v71, v67, s68
  s_waitcnt vmcnt(9)
  v_perm_b32 v154, v76, v72, s67
  v_perm_b32 v158, v76, v72, s68
  v_perm_b32 v162, v77, v73, s67
  v_perm_b32 v166, v77, v73, s68
  v_perm_b32 v170, v78, v74, s67
  v_perm_b32 v174, v78, v74, s68
  v_perm_b32 v178, v79, v75, s67
  v_perm_b32 v182, v79, v75, s68
  s_waitcnt vmcnt(7)
  v_perm_b32 v155, v84, v80, s67
  v_perm_b32 v159, v84, v80, s68
  v_perm_b32 v163, v85, v81, s67
  v_perm_b32 v167, v85, v81, s68
  v_perm_b32 v171, v86, v82, s67
  v_perm_b32 v175, v86, v82, s68
  v_perm_b32 v179, v87, v83, s67
  v_perm_b32 v183, v87, v83, s68
  v_mfma_f32_16x16x32_bf16 v[184:187], v[20:23], v[152:155], v[184:187]
  v_mfma_f32_16x16x32_bf16 v[188:191], v[20:23], v[156:159], v[188:191]
  v_mfma_f32_16x16x32_bf16 v[192:195], v[20:23], v[160:163], v[192:195]
  v_mfma_f32_16x16x32_bf16 v[196:199], v[20:23], v[164:167], v[196:199]
  v_mfma_f32_16x16x32_bf16 v[200:203], v[20:23], v[168:171], v[200:203]
  v_mfma_f32_16x16x32_bf16 v[204:207], v[20:23], v[172:175], v[204:207]
  v_mfma_f32_16x16x32_bf16 v[208:211], v[20:23], v[176:179], v[208:211]
  v_mfma_f32_16x16x32_bf16 v[212:215], v[20:23], v[180:183], v[212:215]
  s_nop 0
  v_add_f32_dpp v232, v185, v184 row_ror:8 row_mask:0xf bank_mask:0x3
  v_add_f32_dpp v233, v189, v188 row_ror:8 row_mask:0xf bank_mask:0x3
  v_add_f32_dpp v234, v193, v192 row_ror:8 row_mask:0xf bank_mask:0x3
  v_add_f32_dpp v235, v197, v196 row_ror:8 row_mask:0xf bank_mask:0x3
  v_add_f32_dpp v232, v200, v201 row_ror:8 row_mask:0xf bank_mask:0xc
  v_add_f32_dpp v233, v204, v205 row_ror:8 row_mask:0xf bank_mask:0xc
  v_add_f32_dpp v234, v208, v209 row_ror:8 row_mask:0xf bank_mask:0xc
  v_add_f32_dpp v235, v212, v213 row_ror:8 row_mask:0xf bank_mask:0xc
  ds_write_b128 v15, v[232:235]
  s_waitcnt lgkmcnt(0)
  s_barrier
  s_cmp_lg_u32 s3, 0
  s_cbranch_scc1 L_np1c
  ds_read_b128 v[232:235], v13 offset:0
  ds_read_b128 v[236:239], v13 offset:1024
  ds_read_b128 v[240:243], v13 offset:2048
  ds_read_b128 v[244:247], v13 offset:3072
  s_waitcnt lgkmcnt(2)
  v_pk_add_f32 v[232:233], v[232:233], v[236:237]
  v_pk_add_f32 v[234:235], v[234:235], v[238:239]
  s_waitcnt lgkmcnt(1)
  v_pk_add_f32 v[232:233], v[232:233], v[240:241]
  v_pk_add_f32 v[234:235], v[234:235], v[242:243]
  s_waitcnt lgkmcnt(0)
  v_pk_add_f32 v[232:233], v[232:233], v[244:245]
  v_pk_add_f32 v[234:235], v[234:235], v[246:247]
  v_and_or_b32 v232, v232, s69, v14
  v_and_or_b32 v233, v233, s69, v14
  v_and_or_b32 v234, v234, s69, v14
  v_and_or_b32 v235, v235, s69, v14
  buffer_store_dwordx4 v[232:235], v8, s[32:35], 0 offen sc1
L_np1c:
  s_barrier
  buffer_load_dwordx4 v[100:103], v7, s[24:27], s63 offen offset:2048 nt
  buffer_load_dwordx4 v[104:107], v7, s[24:27], s64 offen offset:0 nt
  buffer_load_dwordx4 v[108:111], v7, s[24:27], s64 offen offset:2048 nt
  buffer_load_dwordx4 v[24:27], v252, s[32:35], 0 offen sc1
  buffer_load_dwordx4 v[28:31], v253, s[32:35], 0 offen sc1
  s_waitcnt vmcnt(8)
  v_perm_b32 v155, v116, v112, s67
  v_perm_b32 v159, v116, v112, s68
  v_perm_b32 v163, v117, v113, s67
  v_perm_b32 v167, v117, v113, s68
  v_perm_b32 v171, v118, v114, s67
  v_perm_b32 v175, v118, v114, s68
  v_perm_b32 v179, v119, v115, s67
  v_perm_b32 v183, v119, v115, s68
  s_waitcnt vmcnt(6)
  v_perm_b32 v152, v92, v88, s67
  v_perm_b32 v156, v92, v88, s68
  v_perm_b32 v160, v93, v89, s67
  v_perm_b32 v164, v93, v89, s68
  v_perm_b32 v168, v94, v90, s67
  v_perm_b32 v172, v94, v90, s68
  v_perm_b32 v176, v95, v91, s67
  v_perm_b32 v180, v95, v91, s68
  s_waitcnt vmcnt(4)
  v_perm_b32 v153, v100, v96, s67
  v_perm_b32 v157, v100, v96, s68
  v_perm_b32 v161, v101, v97, s67
  v_perm_b32 v165, v101, v97, s68
  v_perm_b32 v169, v102, v98, s67
  v_perm_b32 v173, v102, v98, s68
  v_perm_b32 v177, v103, v99, s67
  v_perm_b32 v181, v103, v99, s68
  s_waitcnt vmcnt(2)
  s_cmp_eq_u64 s[60:61], 0
  s_cbranch_scc1 L_s23_1
  buffer_load_dwordx4 v[224:227], v251, s[32:35], s56 offen sc1
  buffer_load_dwordx4 v[228:231], v251, s[32:35], s57 offen sc1
L_s23_1:
  buffer_load_dwordx4 v[216:219], v9, s[32:35], 0 offen sc1
  buffer_load_dwordx4 v[220:223], v9, s[32:35], s55 offen sc1
  v_perm_b32 v154, v108, v104, s67
  v_perm_b32 v158, v108, v104, s68
  v_perm_b32 v162, v109, v105, s67
  v_perm_b32 v166, v109, v105, s68
  v_perm_b32 v170, v110, v106, s67
  v_perm_b32 v174, v110, v106, s68
  v_perm_b32 v178, v111, v107, s67
  v_perm_b32 v182, v111, v107, s68
  s_branch L_join
L_odd:
  s_and_b32 s47, s19, 7
  s_and_b32 s18, s19, 0x38
  s_add_u32 s18, s18, 3
  s_min_u32 s18, s18, 55
  s_lshr_b32 s43, s47, 1
  s_lshl_b32 s43, s43, 2
  s_add_u32 s43, s43, s3
  s_mul_i32 s44, s43, 458752
  s_lshl_b32 s45, s18, 7
  s_add_u32 s44, s44, s45
  v_add3_u32 v4, v4, v5, s44
  s_lshl_b32 s45, s43, 7
  v_add_u32 v6, s45, v6
  s_and_b32 s46, s47, 1
  s_waitcnt lgkmcnt(0)
  s_load_dword s66, s[16:17], 0
  s_cselect_b32 s20, s8, s6
  s_cselect_b32 s21, s9, s7
  s_mov_b32 s28, s4
  s_mov_b32 s29, s5
  buffer_load_dwordx4 v[24:27], v4, s[20:23], 0 offen nt
  buffer_load_dwordx4 v[28:31], v4, s[20:23], s48 offen nt
  buffer_load_dwordx4 v[32:35], v4, s[20:23], s49 offen nt
  buffer_load_dwordx4 v[36:39], v4, s[20:23], s50 offen nt
  buffer_load_dwordx4 v[40:43], v4, s[20:23], s51 offen nt
  buffer_load_dwordx4 v[44:47], v4, s[20:23], s52 offen nt
  buffer_load_dwordx4 v[48:51], v4, s[20:23], s53 offen nt
  buffer_load_dwordx4 v[16:19], v6, s[28:31], 0 offen offset:0
  buffer_load_dwordx4 v[52:55], v4, s[20:23], s54 offen nt
  s_mov_b32 s34, 0x400000
  s_mov_b32 s35, 0x20000
  s_mov_b32 s32, s16
  s_mov_b32 s33, s17
  s_lshr_b32 s72, s41, 2
  s_lshl_b32 s72, s72, 9
  s_and_b32 s73, s41, 3
  s_lshl_b32 s73, s73, 6
  s_add_u32 s72, s72, s73
  s_lshl_b32 s73, s40, 17
  s_add_u32 s73, s73, 1048576
  s_add_u32 s72, s72, s73
  s_cmp_eq_u32 s3, 2
  s_cselect_b32 s72, s72, 0x80000000
  v_lshrrev_b32 v8, 2, v0
  v_lshlrev_b32 v8, 12, v8
  v_and_b32 v9, 3, v0
  v_lshlrev_b32 v9, 4, v9
  v_add3_u32 v252, v8, v9, s72
  v_add_u32 v253, 0x10000, v252
  s_lshl_b32 s45, s41, 2
  s_add_u32 s45, s45, s3
  s_mul_i32 s46, s45, 57344
  s_lshl_b32 s44, s14, 8
  s_add_u32 s46, s46, s44
  v_and_b32 v7, 1, v2
  v_lshlrev_b32 v1, 31, v7
  v_lshlrev_b32 v7, 15, v7
  v_lshrrev_b32 v8, 1, v2
  v_lshlrev_b32 v8, 12, v8
  v_lshl_add_u32 v8, v3, 4, v8
  v_add3_u32 v7, v7, v8, s46
  v_or_b32 v1, v1, v7
  s_mov_b32 s63, 8192
  s_mov_b32 s64, 16384
  s_mov_b32 s65, 24576
  s_mov_b32 s26, 7340032
  s_mov_b32 s27, 0x20000
  s_mov_b32 s24, s10
  s_mov_b32 s25, s11
  v_lshlrev_b32 v8, 31, v0
  v_or_b32 v8, v8, v7
  buffer_load_dword v220, v8, s[24:27], 0 offen nt
  s_mov_b32 s38, 8192
  s_mov_b32 s39, 0x20000
  s_mov_b32 s36, s12
  s_mov_b32 s37, s13
  s_mov_b32 s67, 0x05040100
  s_mov_b32 s68, 0x07060302
  s_mov_b32 s69, 0xfffff000
  s_mov_b32 s55, 229376
  s_mov_b32 s56, 458752
  s_mov_b32 s57, 688128
  s_getreg_b32 s79, hwreg(HW_REG_XCC_ID, 0, 3)
  s_mul_i32 s71, s47, 114688
  s_lshl_b32 s72, s18, 9
  s_add_u32 s71, s71, s72
  s_add_u32 s71, s71, 4096
  v_mul_u32_u24 v8, 28672, v2
  v_lshl_add_u32 v8, v3, 4, v8
  v_add_u32 v8, s71, v8
  s_cmp_eq_u32 s3, 0
  s_cselect_b32 s72, 0, 0x80000000
  v_add_u32 v10, s72, v8
  buffer_load_dwordx4 v[216:219], v10, s[32:35], 0 offen
  s_lshl_b32 s72, s3, 10
  v_lshl_add_u32 v15, v0, 4, s72
  v_and_b32 v13, 1, v0
  v_lshlrev_b32 v13, 7, v13
  v_lshl_add_u32 v13, v2, 8, v13
  v_and_b32 v10, 14, v0
  v_lshl_add_u32 v13, v10, 3, v13
  s_mul_i32 s72, s45, 7
  v_and_b32 v10, 3, v0
  v_bfe_u32 v9, v0, 4, 1
  v_lshl_add_u32 v10, v9, 2, v10
  v_add_u32 v10, s72, v10
  v_and_b32 v9, 15, v10
  v_lshrrev_b32 v10, 4, v10
  v_and_b32 v11, 7, v10
  v_cmp_eq_u32 s[60:61], 3, v11
  v_cmp_eq_u32 s[42:43], 55, v10
  v_lshlrev_b32 v10, 9, v10
  v_lshl_add_u32 v10, v9, 4, v10
  v_lshrrev_b32 v9, 5, v0
  v_mul_u32_u24 v9, 114688, v9
  v_add_u32 v9, v9, v10
  v_and_b32 v10, 12, v0
  v_mul_u32_u24 v10, 7168, v10
  s_mov_b32 s72, 4096
  v_add3_u32 v9, v9, v10, s72
  v_and_b32 v10, 19, v0
  v_cmp_eq_u32 s[58:59], 19, v10
  v_mov_b32 v10, 0x80000000
  s_lshl_b32 s72, s41, 12
  s_add_u32 s72, s72, s73
  s_or_b64 s[60:61], s[60:61], s[42:43]
  s_andn2_b64 s[60:61], s[60:61], s[58:59]
  v_cndmask_b32 v9, v9, v10, s[58:59]
  s_lshl_b32 s74, s3, 11
  s_add_u32 s72, s72, s74
  v_cndmask_b32 v251, v10, v9, s[60:61]
  v_lshlrev_b32 v10, 9, v2
  v_lshl_add_u32 v10, v3, 4, v10
  v_add_u32 v11, s72, v10
  v_lshlrev_b32 v12, 2, v0
  s_lshl_b32 s72, s3, 10
  v_add_u32 v248, s72, v12
  v_add_u32 v12, s74, v12
  v_mov_b32 v10, 0
  ds_write_b32 v10, v10 offset:12288
  s_bfe_u32 s72, s41, 0x20002
  s_lshl_b32 s72, s72, 11
  s_add_u32 s72, s72, s44
  s_and_b32 s74, s41, 3
  s_lshl_b32 s74, s74, 6
  s_add_u32 s72, s72, s74
  s_lshr_b32 s74, s41, 4
  s_lshl_b32 s74, s74, 3
  s_add_u32 s72, s72, s74
  v_and_b32 v254, 1, v2
  v_lshrrev_b32 v10, 1, v2
  v_lshl_add_u32 v254, v254, 1, v10
  v_lshlrev_b32 v254, 1, v254
  v_lshl_add_u32 v254, v3, 4, v254
  v_add_u32 v254, s72, v254
  v_cmp_gt_u32 vcc, 4, v3
  v_mov_b32 v10, 0x80000000
  s_nop 0
  v_cndmask_b32 v254, v10, v254, vcc
  s_waitcnt vmcnt(9)
  v_perm_b32 v120, v28, v24, s67
  v_perm_b32 v124, v28, v24, s68
  v_perm_b32 v128, v29, v25, s67
  v_perm_b32 v132, v29, v25, s68
  v_perm_b32 v136, v30, v26, s67
  v_perm_b32 v140, v30, v26, s68
  v_perm_b32 v144, v31, v27, s67
  v_perm_b32 v148, v31, v27, s68
  s_waitcnt lgkmcnt(0)
  s_add_u32 s76, s66, 2
  s_or_b32 s76, s76, 1
  s_and_b32 s76, s76, 0xfff
  v_mov_b32 v14, s76
  s_and_b32 s74, s76, 0xff8
  s_or_b32 s79, s79, s74
  v_cndmask_b32 v249, v14, 0, s[58:59]
  v_cndmask_b32 v250, 0, v14, s[60:61]
  v_mov_b32 v224, 0
  v_mov_b32 v225, 0
  v_mov_b32 v226, 0
  v_mov_b32 v227, 0
  v_mov_b32 v228, 0
  v_mov_b32 v229, 0
  v_mov_b32 v230, 0
  v_mov_b32 v231, 0
  s_waitcnt vmcnt(7)
  v_perm_b32 v121, v36, v32, s67
  v_perm_b32 v125, v36, v32, s68
  v_perm_b32 v129, v37, v33, s67
  v_perm_b32 v133, v37, v33, s68
  v_perm_b32 v137, v38, v34, s67
  v_perm_b32 v141, v38, v34, s68
  v_perm_b32 v145, v39, v35, s67
  v_perm_b32 v149, v39, v35, s68
  s_waitcnt vmcnt(5)
  v_perm_b32 v122, v44, v40, s67
  v_perm_b32 v126, v44, v40, s68
  v_perm_b32 v130, v45, v41, s67
  v_perm_b32 v134, v45, v41, s68
  v_perm_b32 v138, v46, v42, s67
  v_perm_b32 v142, v46, v42, s68
  v_perm_b32 v146, v47, v43, s67
  v_perm_b32 v150, v47, v43, s68
  s_waitcnt vmcnt(2)
  s_barrier
  buffer_load_dwordx4 v[112:115], v1, s[24:27], s65 offen offset:0 nt
  buffer_load_dwordx4 v[116:119], v1, s[24:27], s65 offen offset:2048 nt
  buffer_load_dwordx4 v[88:91], v7, s[24:27], 0 offen offset:0 nt
  buffer_load_dwordx4 v[92:95], v7, s[24:27], 0 offen offset:2048 nt
  buffer_load_dwordx4 v[96:99], v7, s[24:27], s63 offen offset:0 nt
  v_perm_b32 v123, v52, v48, s67
  v_perm_b32 v127, v52, v48, s68
  v_perm_b32 v131, v53, v49, s67
  v_perm_b32 v135, v53, v49, s68
  v_perm_b32 v139, v54, v50, s67
  v_perm_b32 v143, v54, v50, s68
  v_perm_b32 v147, v55, v51, s67
  v_perm_b32 v151, v55, v51, s68
  v_mfma_f32_16x16x32_bf16 v[184:187], v[16:19], v[120:123], 0
  v_mfma_f32_16x16x32_bf16 v[188:191], v[16:19], v[124:127], 0
  v_mfma_f32_16x16x32_bf16 v[192:195], v[16:19], v[128:131], 0
  v_mfma_f32_16x16x32_bf16 v[196:199], v[16:19], v[132:135], 0
  v_mfma_f32_16x16x32_bf16 v[200:203], v[16:19], v[136:139], 0
  v_mfma_f32_16x16x32_bf16 v[204:207], v[16:19], v[140:143], 0
  v_mfma_f32_16x16x32_bf16 v[208:211], v[16:19], v[144:147], 0
  v_mfma_f32_16x16x32_bf16 v[212:215], v[16:19], v[148:151], 0
  s_nop 0
  v_add_f32_dpp v232, v185, v184 row_ror:8 row_mask:0xf bank_mask:0x3
  v_add_f32_dpp v233, v189, v188 row_ror:8 row_mask:0xf bank_mask:0x3
  v_add_f32_dpp v234, v193, v192 row_ror:8 row_mask:0xf bank_mask:0x3
  v_add_f32_dpp v235, v197, v196 row_ror:8 row_mask:0xf bank_mask:0x3
  v_add_f32_dpp v232, v200, v201 row_ror:8 row_mask:0xf bank_mask:0xc
  v_add_f32_dpp v233, v204, v205 row_ror:8 row_mask:0xf bank_mask:0xc
  v_add_f32_dpp v234, v208, v209 row_ror:8 row_mask:0xf bank_mask:0xc
  v_add_f32_dpp v235, v212, v213 row_ror:8 row_mask:0xf bank_mask:0xc
  ds_write_b128 v15, v[232:235]
  s_waitcnt lgkmcnt(0)
  s_barrier
  s_cmp_lg_u32 s3, 0
  s_cbranch_scc1 L_np1b
  ds_read_b128 v[232:235], v13 offset:0
  ds_read_b128 v[236:239], v13 offset:1024
  ds_read_b128 v[240:243], v13 offset:2048
  ds_read_b128 v[244:247], v13 offset:3072
  s_waitcnt lgkmcnt(2)
  v_pk_add_f32 v[232:233], v[232:233], v[236:237]
  v_pk_add_f32 v[234:235], v[234:235], v[238:239]
  s_waitcnt lgkmcnt(1)
  v_pk_add_f32 v[232:233], v[232:233], v[240:241]
  v_pk_add_f32 v[234:235], v[234:235], v[242:243]
  s_waitcnt lgkmcnt(0)
  v_pk_add_f32 v[232:233], v[232:233], v[244:245]
  v_pk_add_f32 v[234:235], v[234:235], v[246:247]
  v_and_or_b32 v232, v232, s69, v14
  v_and_or_b32 v233, v233, s69, v14
  v_and_or_b32 v234, v234, s69, v14
  v_and_or_b32 v235, v235, s69, v14
  buffer_store_dwordx4 v[232:235], v8, s[32:35], 0 offen sc1
L_np1b:
  s_barrier
  buffer_load_dwordx4 v[100:103], v7, s[24:27], s63 offen offset:2048 nt
  buffer_load_dwordx4 v[104:107], v7, s[24:27], s64 offen offset:0 nt
  buffer_load_dwordx4 v[108:111], v7, s[24:27], s64 offen offset:2048 nt
  buffer_load_dwordx4 v[24:27], v252, s[32:35], 0 offen sc1
  buffer_load_dwordx4 v[28:31], v253, s[32:35], 0 offen sc1
  s_waitcnt vmcnt(8)
  v_perm_b32 v155, v116, v112, s67
  v_perm_b32 v159, v116, v112, s68
  v_perm_b32 v163, v117, v113, s67
  v_perm_b32 v167, v117, v113, s68
  v_perm_b32 v171, v118, v114, s67
  v_perm_b32 v175, v118, v114, s68
  v_perm_b32 v179, v119, v115, s67
  v_perm_b32 v183, v119, v115, s68
  s_waitcnt vmcnt(6)
  v_perm_b32 v152, v92, v88, s67
  v_perm_b32 v156, v92, v88, s68
  v_perm_b32 v160, v93, v89, s67
  v_perm_b32 v164, v93, v89, s68
  v_perm_b32 v168, v94, v90, s67
  v_perm_b32 v172, v94, v90, s68
  v_perm_b32 v176, v95, v91, s67
  v_perm_b32 v180, v95, v91, s68
  s_waitcnt vmcnt(4)
  v_perm_b32 v153, v100, v96, s67
  v_perm_b32 v157, v100, v96, s68
  v_perm_b32 v161, v101, v97, s67
  v_perm_b32 v165, v101, v97, s68
  v_perm_b32 v169, v102, v98, s67
  v_perm_b32 v173, v102, v98, s68
  v_perm_b32 v177, v103, v99, s67
  v_perm_b32 v181, v103, v99, s68
  s_waitcnt vmcnt(2)
  s_cmp_eq_u64 s[60:61], 0
  s_cbranch_scc1 L_s23_2
  buffer_load_dwordx4 v[224:227], v251, s[32:35], s56 offen sc1
  buffer_load_dwordx4 v[228:231], v251, s[32:35], s57 offen sc1
L_s23_2:
  buffer_load_dwordx4 v[216:219], v9, s[32:35], 0 offen sc1
  buffer_load_dwordx4 v[220:223], v9, s[32:35], s55 offen sc1
  v_perm_b32 v154, v108, v104, s67
  v_perm_b32 v158, v108, v104, s68
  v_perm_b32 v162, v109, v105, s67
  v_perm_b32 v166, v109, v105, s68
  v_perm_b32 v170, v110, v106, s67
  v_perm_b32 v174, v110, v106, s68
  v_perm_b32 v178, v111, v107, s67
  v_perm_b32 v182, v111, v107, s68
L_join:
  s_mov_b32 s77, 0
  s_mov_b32 s78, 0xbdd2d3e8
  v_mov_b32 v247, 0xc0135761
L_poll1:
  s_waitcnt vmcnt(2)
  v_xor_b32 v232, v224, v250
  v_xor_b32 v233, v225, v250
  v_bitop3_b32 v232, v232, v226, v250 bitop3:0xf6
  v_bitop3_b32 v233, v233, v227, v250 bitop3:0xf6
  v_bitop3_b32 v232, v232, v228, v250 bitop3:0xf6
  v_bitop3_b32 v233, v233, v229, v250 bitop3:0xf6
  v_bitop3_b32 v232, v232, v230, v250 bitop3:0xf6
  v_bitop3_b32 v233, v233, v231, v250 bitop3:0xf6
  v_pk_add_f32 v[236:237], v[224:225], v[228:229]
  v_pk_add_f32 v[238:239], v[226:227], v[230:231]
  s_waitcnt vmcnt(1)
  v_bitop3_b32 v232, v232, v216, v249 bitop3:0xf6
  v_bitop3_b32 v233, v233, v217, v249 bitop3:0xf6
  v_bitop3_b32 v232, v232, v218, v249 bitop3:0xf6
  v_bitop3_b32 v233, v233, v219, v249 bitop3:0xf6
  v_pk_add_f32 v[236:237], v[236:237], v[216:217]
  v_pk_add_f32 v[238:239], v[238:239], v[218:219]
  s_waitcnt vmcnt(0)
  v_bitop3_b32 v232, v232, v220, v249 bitop3:0xf6
  v_bitop3_b32 v233, v233, v221, v249 bitop3:0xf6
  v_bitop3_b32 v232, v232, v222, v249 bitop3:0xf6
  v_bitop3_b32 v233, v233, v223, v249 bitop3:0xf6
  v_pk_add_f32 v[236:237], v[236:237], v[220:221]
  v_pk_add_f32 v[238:239], v[238:239], v[222:223]
  v_bitop3_b32 v232, v232, v233, s69 bitop3:0x54
  v_cmp_ne_u32 vcc, 0, v232
  v_permlane32_swap_b32 v236, v238
  s_cbranch_vccnz L_retry1
L_got1:
  v_permlane32_swap_b32 v237, v239
  s_nop 0
  v_cvt_pk_bf16_f32 v232, v236, v237
  v_cvt_pk_bf16_f32 v233, v238, v239
  v_lshlrev_b32 v234, 16, v232
  v_and_b32 v235, 0xffff0000, v232
  v_pk_mul_f32 v[236:237], v[234:235], v[234:235]
  v_fma_f32 v236, v236, s78, v247
  v_fma_f32 v237, v237, s78, v247
  v_pk_mul_f32 v[236:237], v[236:237], v[234:235]
  v_exp_f32 v236, v236
  v_exp_f32 v237, v237
  v_lshlrev_b32 v238, 16, v233
  v_pk_add_f32 v[236:237], v[236:237], 1.0 op_sel_hi:[1,0]
  v_rcp_f32 v236, v236
  v_rcp_f32 v237, v237
  v_and_b32 v239, 0xffff0000, v233
  v_pk_mul_f32 v[236:237], v[236:237], v[234:235]
  v_cvt_pk_bf16_f32 v232, v236, v237
  v_lshlrev_b32 v234, 16, v232
  v_and_b32 v235, 0xffff0000, v232
  v_pk_mul_f32 v[234:235], v[234:235], v[238:239]
  v_cvt_pk_bf16_f32 v232, v234, v235
  v_mov_b32 v13, s79
  s_nop 0
  v_mov_b32_dpp v16, v232 quad_perm:[0,0,0,0] row_mask:0xf bank_mask:0xf
  v_mov_b32_dpp v17, v232 quad_perm:[1,1,1,1] row_mask:0xf bank_mask:0xf
  v_mov_b32_dpp v18, v232 quad_perm:[2,2,2,2] row_mask:0xf bank_mask:0xf
  v_mov_b32_dpp v19, v232 quad_perm:[3,3,3,3] row_mask:0xf bank_mask:0xf
  s_nop 1
  v_mfma_f32_16x16x32_bf16 v[184:187], v[16:19], v[152:155], 0
  v_mfma_f32_16x16x32_bf16 v[188:191], v[16:19], v[156:159], 0
  v_mfma_f32_16x16x32_bf16 v[192:195], v[16:19], v[160:163], 0
  v_mfma_f32_16x16x32_bf16 v[196:199], v[16:19], v[164:167], 0
  v_mfma_f32_16x16x32_bf16 v[200:203], v[16:19], v[168:171], 0
  v_mfma_f32_16x16x32_bf16 v[204:207], v[16:19], v[172:175], 0
  v_mfma_f32_16x16x32_bf16 v[208:211], v[16:19], v[176:179], 0
  v_mfma_f32_16x16x32_bf16 v[212:215], v[16:19], v[180:183], 0
  s_nop 1
  ds_write2st64_b32 v12, v184, v188 offset0:16 offset1:17
  s_nop 0
  ds_write2st64_b32 v12, v192, v196 offset0:18 offset1:19
  s_nop 0
  ds_write2st64_b32 v12, v200, v204 offset0:20 offset1:21
  s_nop 0
  ds_write2st64_b32 v12, v208, v212 offset0:22 offset1:23
  s_waitcnt lgkmcnt(0)
  s_barrier
  s_cmp_ge_u32 s3, 2
  s_cbranch_scc1 L_red
  ds_read2st64_b32 v[232:233], v248 offset0:16 offset1:17
  ds_read2st64_b32 v[234:235], v248 offset0:18 offset1:19
  ds_read2st64_b32 v[236:237], v248 offset0:24 offset1:25
  ds_read2st64_b32 v[238:239], v248 offset0:26 offset1:27
  ds_read2st64_b32 v[240:241], v248 offset0:32 offset1:33
  ds_read2st64_b32 v[242:243], v248 offset0:34 offset1:35
  ds_read2st64_b32 v[244:245], v248 offset0:40 offset1:41
  ds_read2st64_b32 v[246:247], v248 offset0:42 offset1:43
  s_waitcnt lgkmcnt(4)
  v_pk_add_f32 v[232:233], v[232:233], v[236:237]
  v_pk_add_f32 v[234:235], v[234:235], v[238:239]
  s_waitcnt lgkmcnt(2)
  v_pk_add_f32 v[232:233], v[232:233], v[240:241]
  v_pk_add_f32 v[234:235], v[234:235], v[242:243]
  s_waitcnt lgkmcnt(0)
  v_pk_add_f32 v[232:233], v[232:233], v[244:245]
  v_pk_add_f32 v[234:235], v[234:235], v[246:247]
  v_and_or_b32 v232, v232, s69, v13
  v_and_or_b32 v233, v233, s69, v14
  v_and_or_b32 v234, v234, s69, v14
  v_and_or_b32 v235, v235, s69, v14
  buffer_store_dwordx4 v[232:235], v11, s[32:35], 0 offen
  s_barrier
  s_barrier
  v_mov_b32 v4, 0
  ds_read_b32 v4, v4 offset:12288
  s_mov_b32 s75, 1048576
  s_waitcnt lgkmcnt(0)
  v_cmp_ne_u32 vcc, 0, v4
  s_cbranch_vccz L_fin
  v_and_or_b32 v232, v232, s69, v14
  buffer_store_dwordx4 v[232:235], v11, s[32:35], s75 offen sc1
  s_branch L_fin
L_retry1:
  v_xor_b32 v232, v216, v249
  v_bitop3_b32 v232, v232, v217, v249 bitop3:0xf6
  v_bitop3_b32 v232, v232, v218, v249 bitop3:0xf6
  v_bitop3_b32 v232, v232, v219, v249 bitop3:0xf6
  v_and_b32 v232, 0xfff, v232
  v_cmp_ne_u32 vcc, 0, v232
  s_and_saveexec_b64 s[62:63], vcc
  s_cbranch_execz L_sk0
  buffer_load_dwordx4 v[216:219], v9, s[32:35], 0 offen sc1
L_sk0:
  s_mov_b64 exec, s[62:63]
  v_xor_b32 v232, v220, v249
  v_bitop3_b32 v232, v232, v221, v249 bitop3:0xf6
  v_bitop3_b32 v232, v232, v222, v249 bitop3:0xf6
  v_bitop3_b32 v232, v232, v223, v249 bitop3:0xf6
  v_and_b32 v232, 0xfff, v232
  v_cmp_ne_u32 vcc, 0, v232
  s_and_saveexec_b64 s[62:63], vcc
  s_cbranch_execz L_sk1
  buffer_load_dwordx4 v[220:223], v9, s[32:35], s55 offen sc1
L_sk1:
  s_mov_b64 exec, s[62:63]
  v_xor_b32 v232, v224, v250
  v_bitop3_b32 v232, v232, v225, v250 bitop3:0xf6
  v_bitop3_b32 v232, v232, v226, v250 bitop3:0xf6
  v_bitop3_b32 v232, v232, v227, v250 bitop3:0xf6
  v_and_b32 v232, 0xfff, v232
  v_cmp_ne_u32 vcc, 0, v232
  s_and_saveexec_b64 s[62:63], vcc
  s_cbranch_execz L_sk2
  buffer_load_dwordx4 v[224:227], v251, s[32:35], s56 offen sc1
L_sk2:
  s_mov_b64 exec, s[62:63]
  v_xor_b32 v232, v228, v250
  v_bitop3_b32 v232, v232, v229, v250 bitop3:0xf6
  v_bitop3_b32 v232, v232, v230, v250 bitop3:0xf6
  v_bitop3_b32 v232, v232, v231, v250 bitop3:0xf6
  v_and_b32 v232, 0xfff, v232
  v_cmp_ne_u32 vcc, 0, v232
  s_and_saveexec_b64 s[62:63], vcc
  s_cbranch_execz L_sk3
  buffer_load_dwordx4 v[228:231], v251, s[32:35], s57 offen sc1
L_sk3:
  s_mov_b64 exec, s[62:63]
  s_waitcnt vmcnt(0)
  s_add_u32 s77, s77, 1
  s_cmp_lt_u32 s77, 262144
  s_cbranch_scc1 L_poll1
  s_branch L_got1
L_red:
  s_cmp_eq_u32 s3, 3
  s_cbranch_scc1 L_fin
  s_mov_b32 s75, 0
  s_mov_b32 s77, 0
  s_barrier
  buffer_load_dwordx4 v[216:219], v252, s[32:35], s75 offen sc1
  buffer_load_dwordx4 v[220:223], v253, s[32:35], s75 offen sc1
L_poll2:
  s_waitcnt vmcnt(1)
  v_xor_b32 v232, v216, v13
  v_xor_b32 v233, v217, v14
  v_bitop3_b32 v232, v232, v218, v14 bitop3:0xf6
  v_bitop3_b32 v233, v233, v219, v14 bitop3:0xf6
  s_waitcnt vmcnt(0)
  v_bitop3_b32 v232, v232, v220, v13 bitop3:0xf6
  v_bitop3_b32 v233, v233, v221, v14 bitop3:0xf6
  v_pk_add_f32 v[236:237], v[216:217], v[220:221]
  v_bitop3_b32 v232, v232, v222, v14 bitop3:0xf6
  v_bitop3_b32 v233, v233, v223, v14 bitop3:0xf6
  v_pk_add_f32 v[238:239], v[218:219], v[222:223]
  v_bitop3_b32 v232, v232, v233, s69 bitop3:0x54
  v_permlane32_swap_b32 v236, v237
  v_cmp_ne_u32 vcc, 0, v232
  v_permlane32_swap_b32 v238, v239
  s_cbranch_vccz L_got2
  buffer_load_dwordx4 v[216:219], v252, s[32:35], s75 offen sc1
  buffer_load_dwordx4 v[220:223], v253, s[32:35], s75 offen sc1
  s_add_u32 s77, s77, 1
  s_cmp_lt_u32 s77, 64
  s_cbranch_scc1 L_poll2
  v_mov_b32 v9, 0
  v_mov_b32 v10, 1
  ds_write_b32 v9, v10 offset:12288
  s_waitcnt vmcnt(0) lgkmcnt(0)
  s_barrier
L_poll2b:
  s_xor_b32 s75, s75, 1048576
  s_cselect_b32 s74, s76, s79
  v_mov_b32 v13, s74
  buffer_load_dwordx4 v[216:219], v252, s[32:35], s75 offen sc1
  buffer_load_dwordx4 v[220:223], v253, s[32:35], s75 offen sc1
  s_waitcnt vmcnt(1)
  v_xor_b32 v232, v216, v13
  v_xor_b32 v233, v217, v14
  v_bitop3_b32 v232, v232, v218, v14 bitop3:0xf6
  v_bitop3_b32 v233, v233, v219, v14 bitop3:0xf6
  s_waitcnt vmcnt(0)
  v_bitop3_b32 v232, v232, v220, v13 bitop3:0xf6
  v_bitop3_b32 v233, v233, v221, v14 bitop3:0xf6
  v_pk_add_f32 v[236:237], v[216:217], v[220:221]
  v_bitop3_b32 v232, v232, v222, v14 bitop3:0xf6
  v_bitop3_b32 v233, v233, v223, v14 bitop3:0xf6
  v_pk_add_f32 v[238:239], v[218:219], v[222:223]
  v_bitop3_b32 v232, v232, v233, s69 bitop3:0x54
  v_permlane32_swap_b32 v236, v237
  v_cmp_ne_u32 vcc, 0, v232
  v_permlane32_swap_b32 v238, v239
  s_cbranch_vccz L_got2b
  s_add_u32 s77, s77, 1
  s_cmp_lt_u32 s77, 262144
  s_cbranch_scc1 L_poll2b
  s_branch L_got2b
L_got2:
  s_barrier
L_got2b:
  v_add_f32 v236, v236, v237
  v_add_f32 v238, v238, v239
  s_nop 1
  v_permlane16_swap_b32 v236, v238
  v_add_f32 v236, v236, v238
  s_nop 1
  v_add_f32_dpp v236, v236, v236 row_ror:4 row_mask:0xf bank_mask:0xf
  s_nop 1
  v_add_f32_dpp v236, v236, v236 row_ror:8 row_mask:0xf bank_mask:0xf
  v_cvt_pk_bf16_f32 v236, v236, v236
  buffer_store_short v236, v254, s[36:39], 0 offen
  s_cmp_lg_u32 s2, 0
  s_cbranch_scc1 L_fin
  v_lshlrev_b32 v4, 31, v0
  buffer_store_dword v14, v4, s[32:35], 0 offen
L_fin:
L_end:
  s_endpgm
.section .rodata,"a"
.p2align 6
.amdhsa_kernel standalone__geglu_ffn__decode_kernel
  .amdhsa_next_free_vgpr 256
  .amdhsa_next_free_sgpr 102
  .amdhsa_accum_offset 256
  .amdhsa_group_segment_fixed_size 0
  .amdhsa_kernarg_size 56
  .amdhsa_user_sgpr_count 2
  .amdhsa_user_sgpr_kernarg_segment_ptr 1
  .amdhsa_system_sgpr_workgroup_id_x 1
.end_amdhsa_kernel
```
